```python
import torch

def _softmax(x, axis=-1):
    return torch.softmax(x, dim=axis)
def _gelu(x):
    return torch.nn.functional.gelu(x, approximate="tanh")
def _silu(x):
    return torch.nn.functional.silu(x)
def _sigmoid(x):
    return torch.sigmoid(x)
def _layernorm(x, axis=-1, eps=1e-5):
    m = x.mean(dim=axis, keepdim=True)
    v = x.var(dim=axis, keepdim=True, unbiased=False)
    return (x - m) / torch.sqrt(v + eps)
def _scatter_add(tgt, idx, src, axis=0):
    return tgt.clone().index_add_(axis, idx, src)
def _segment_sum(src, seg, n):
    out = torch.zeros((n,) + src.shape[1:], dtype=src.dtype)
    return out.index_add_(0, seg, src)
def _pad(x, pw):
    flat = tuple(v for pair in reversed(pw) for v in pair)
    return torch.nn.functional.pad(x, flat)

kernel_name = 'standalone__linear_kernel_rfa__decode'

def setup_inputs():

    _w = (lambda a: (lambda t: t.to(torch.bfloat16) if t.is_floating_point() else t)(torch.as_tensor(a)))
    B, H, Sq, Sk, D, M = 1, 32, 1, 32768, 128, 16
    return {
        "q": _w((lambda *s: torch.randn(*s, dtype=torch.bfloat16) * 0.4)(B, H, Sq, D)),
        "k": _w((lambda *s: torch.randn(*s, dtype=torch.bfloat16) * 1.6)(B, H, Sk, D)),
        "v": _w((lambda *s: torch.randn(*s, dtype=torch.bfloat16) * 1.6)(B, H, Sk, D)),
        "omega": _w((lambda *s: torch.randn(*s, dtype=torch.bfloat16) * 1.6)(M, D)),
    }

def reference(q, k, v, omega):
    d = q.shape[-1]
    m = omega.shape[0]
    scale = float(d) ** -0.25
    qs = q * scale
    ks = k * scale
    q_proj = torch.einsum("bhsd,md->bhsm", qs, omega)
    k_proj = torch.einsum("bhsd,md->bhsm", ks, omega)
    q_sq = 0.5 * torch.einsum("bhsd,bhsd->bhs", qs, qs)[..., None]
    k_sq = 0.5 * torch.einsum("bhsd,bhsd->bhs", ks, ks)[..., None]
    inv_sqrt_m = float(m) ** -0.5
    phi_q = torch.exp(q_proj - q_sq) * inv_sqrt_m + 1e-6
    phi_k = torch.exp(k_proj - k_sq) * inv_sqrt_m + 1e-6
    kv = torch.einsum("bhsm,bhsd->bhmd", phi_k, v)
    z  = torch.einsum("bhsm->bhm", phi_k)
    num = torch.einsum("bhqm,bhmd->bhqd", phi_q, kv)
    den = torch.einsum("bhqm,bhm->bhq", phi_q, z)[..., None] + 1e-6
    return num / den
```

```asm
; @launch grid=(256,1,1) block=(448,1,1) lds=53504
.amdgcn_target "amdgcn-amd-amdhsa--gfx950"
.text
.globl standalone__linear_kernel_rfa__decode_kernel
.p2align 8
.type standalone__linear_kernel_rfa__decode_kernel,@function
standalone__linear_kernel_rfa__decode_kernel:
    s_cmp_ge_u32 s2, 256
    s_cbranch_scc1 L_done
    s_load_dwordx8 s[4:11], s[0:1], 0
    s_load_dwordx4 s[12:15], s[0:1], 32
    s_load_dwordx2 s[16:17], s[0:1], 48
    s_getpc_b64 s[40:41]
L_pc:
    v_lshlrev_b32 v7, 7, v0
    v_min_u32 v7, L_done-L_pc, v7
    global_load_dword v7, v7, s[40:41]
    v_lshrrev_b32 v1, 6, v0
    v_and_b32 v0, 63, v0
    v_readfirstlane_b32 s3, v1
    v_lshrrev_b32 v1, 4, v0
    v_lshlrev_b32 v2, 4, v0
    v_lshlrev_b32 v58, 6, v1
    v_xor_b32 v12, v58, v2
    v_xor_b32 v13, 16, v12
    v_xor_b32 v14, 32, v12
    v_xor_b32 v15, 48, v12
    s_bitcmp1_b32 s2, 3
    s_cselect_b32 s66, 0x27000, 0
    s_bitcmp1_b32 s2, 4
    s_cselect_b32 s48, 0x66a000, 0
    s_xor_b32 s66, s66, s48
    s_bitcmp1_b32 s2, 5
    s_cselect_b32 s48, 0x3a0000, 0
    s_xor_b32 s66, s66, s48
    s_bitcmp1_b32 s2, 6
    s_cselect_b32 s48, 0x710000, 0
    s_xor_b32 s66, s66, s48
    s_bitcmp1_b32 s2, 7
    s_cselect_b32 s48, 0x142000, 0
    s_xor_b32 s66, s66, s48
    s_bitcmp1_b32 s2, 0
    s_cselect_b32 s48, 0x12000, 0
    s_xor_b32 s67, s66, s48
    s_bitcmp1_b32 s2, 1
    s_cselect_b32 s48, 0x331000, 0
    s_xor_b32 s67, s67, s48
    s_bitcmp1_b32 s2, 2
    s_cselect_b32 s48, 0x1b3000, 0
    s_xor_b32 s67, s67, s48
    s_bitcmp1_b32 s3, 0
    s_cselect_b32 s48, 0x20a000, 0
    s_xor_b32 s56, s67, s48
    s_bitcmp1_b32 s3, 1
    s_cselect_b32 s48, 0x18000, 0
    s_xor_b32 s56, s56, s48
    s_bitcmp1_b32 s3, 2
    s_cselect_b32 s48, 0x208000, 0
    s_xor_b32 s56, s56, s48
    s_lshr_b32 s53, s2, 3
    s_lshl_b32 s40, s53, 23
    s_mov_b32 s22, 8388608
    s_mov_b32 s23, 0x20000
    s_and_b32 s44, s3, 3
    s_lshl_b32 s41, s44, 2
    v_add_u32 v3, s41, v1
    v_xor_b32 v4, v3, v0
    v_and_b32 v4, 15, v4
    v_lshlrev_b32 v4, 4, v4
    v_lshl_add_u32 v3, v3, 8, v4
    s_lshl_b32 s41, s53, 8
    s_lshl_b32 s42, s44, 6
    s_add_u32 s41, s41, s42
    v_add_u32 v4, s41, v2
    s_add_u32 s42, s42, 28672
    s_lshl_b32 s43, s44, 10
    s_add_u32 m0, s43, 24576
    s_lshl_b32 s69, s3, 12
    s_cmp_ge_u32 s3, 4
    s_waitcnt lgkmcnt(0)
    s_cbranch_scc1 L_noom
    global_load_lds_dwordx4 v3, s[10:11]
    s_mov_b32 m0, s42
    s_mov_b64 exec, 15
    global_load_lds_dwordx4 v4, s[4:5]
    s_mov_b64 exec, -1
L_noom:
    s_mov_b32 m0, s69
    s_add_u32 s20, s6, s40
    s_addc_u32 s21, s7, 0
    s_cmp_eq_u32 s3, 6
    s_cbranch_scc1 L_setup
    buffer_load_dwordx4 v12, s[20:23], s56 offen offset:0 nt lds
    buffer_load_dwordx4 v13, s[20:23], s56 offen offset:1024 nt lds
    buffer_load_dwordx4 v14, s[20:23], s56 offen offset:2048 nt lds
    buffer_load_dwordx4 v15, s[20:23], s56 offen offset:3072 nt lds
    s_mul_i32 s41, s3, 4096
    v_mov_b32 v64, 0
    v_mov_b32 v65, 0
    v_mov_b32 v66, 0
    v_mov_b32 v67, 0
    v_add_u32 v56, s41, v2
    ds_write_b128 v56, v[64:67] offset:28928
    ds_write_b128 v56, v[64:67] offset:29952
    ds_write_b128 v56, v[64:67] offset:30976
    ds_write_b128 v56, v[64:67] offset:32000
L_setup:
    s_add_u32 s24, s8, s40
    s_addc_u32 s25, s9, 0
    s_mov_b32 s26, 8388608
    s_mov_b32 s27, 0x20000
    s_add_u32 s60, s3, 6
    s_bitcmp1_b32 s60, 0
    s_cselect_b32 s48, 0x20a000, 0
    s_xor_b32 s56, s67, s48
    s_bitcmp1_b32 s60, 1
    s_cselect_b32 s48, 0x18000, 0
    s_xor_b32 s56, s56, s48
    s_bitcmp1_b32 s60, 2
    s_cselect_b32 s48, 0x208000, 0
    s_xor_b32 s56, s56, s48
    s_bitcmp1_b32 s60, 3
    s_cselect_b32 s48, 0x780000, 0
    s_xor_b32 s56, s56, s48
    s_lshl_b32 s60, s60, 6
    s_lshl_b32 s59, s3, 6
    s_mov_b32 s58, 0
    s_mov_b32 s61, 512
    s_mov_b32 s62, 0
    s_mov_b32 s68, 0
    s_mov_b32 s36, 0x3e9837f0
    s_mov_b32 s37, 0x3e9837f0
    s_mov_b32 s50, 0xffff0000
    s_mov_b32 s51, 0x3fb8aa3b
    s_mov_b32 s52, 0x3e800000
    v_mov_b32 v8, 0x358637bd
    v_mov_b32 v6, 1
    v_mov_b32 v5, 28928
    v_mov_b32 v11, 0
    v_and_b32 v63, 15, v0
    v_lshlrev_b32 v59, 2, v1
    v_sub_u32 v58, v63, v59
    v_mov_b32 v59, 0xffff
    v_mov_b32 v60, s50
    v_cmp_eq_u32 vcc, 0, v58
    v_cmp_eq_u32 s[40:41], 1, v58
    v_cmp_eq_u32 s[42:43], 2, v58
    v_cmp_eq_u32 s[44:45], 3, v58
    v_cndmask_b32 v3, 0, v59, vcc
    v_cndmask_b32 v3, v3, v60, s[40:41]
    v_cndmask_b32 v4, 0, v59, s[42:43]
    v_cndmask_b32 v4, v4, v60, s[44:45]
    v_and_b32 v40, 0x3f803f80, v3
    v_and_b32 v41, 0x3f803f80, v4
    v_mov_b32 v42, 0xbf00bf00
    v_mov_b32 v43, 0xbf00bf00
    v_mov_b32 v58, 0x0c0c0302
    v_mov_b32 v59, 0x0c0c0100
    v_cmp_gt_u32 vcc, 8, v63
    v_and_b32 v60, 1, v0
    v_lshlrev_b32 v60, 4, v60
    v_cndmask_b32 v58, v59, v58, vcc
    v_alignbit_b32 v58, v58, v58, v60
    v_bfe_u32 v60, v0, 1, 2
    v_mov_b32 v59, 0x0c0c0c0c
    v_cmp_eq_u32 vcc, 0, v60
    v_cmp_eq_u32 s[40:41], 1, v60
    v_cmp_eq_u32 s[42:43], 2, v60
    v_cmp_eq_u32 s[44:45], 3, v60
    v_cndmask_b32 v20, v59, v58, vcc
    v_cndmask_b32 v21, v59, v58, s[40:41]
    v_cndmask_b32 v22, v59, v58, s[42:43]
    v_cndmask_b32 v23, v59, v58, s[44:45]
    v_lshlrev_b32 v9, 4, v1
    v_lshlrev_b32 v10, 2, v63
    v_xor_b32 v60, v63, v1
    v_lshlrev_b32 v60, 4, v60
    v_lshl_add_u32 v56, v63, 8, v60
    v_xor_b32 v57, 64, v56
    v_xor_b32 v58, 128, v56
    v_xor_b32 v59, 192, v56
    v_and_b32 v61, 3, v0
    v_lshl_add_u32 v60, v61, 10, v60
    v_bfe_u32 v61, v0, 2, 2
    v_lshl_add_u32 v60, v61, 8, v60
    v_add_u32 v16, s69, v60
    v_xor_b32 v17, 64, v16
    v_xor_b32 v18, 128, v16
    v_xor_b32 v19, 192, v16
    s_cmp_eq_u32 s3, 6
    s_waitcnt vmcnt(4) lgkmcnt(0)
    s_barrier
    ds_read_b128 v[24:27], v56 offset:24576
    ds_read_b128 v[28:31], v57 offset:24576
    ds_read_b128 v[32:35], v58 offset:24576
    ds_read_b128 v[36:39], v59 offset:24576
    s_cbranch_scc0 L_topK
    ds_read_b128 v[80:83], v9 offset:28672
    ds_read_b128 v[84:87], v9 offset:28736
    ds_read_b128 v[88:91], v9 offset:28800
    ds_read_b128 v[92:95], v9 offset:28864
    s_mov_b32 s58, 3
    s_branch L_K_have
L_topK:
    s_waitcnt vmcnt(0)
    ds_read_b128 v[80:83], v16
    ds_read_b128 v[84:87], v17
    ds_read_b128 v[88:91], v18
    ds_read_b128 v[92:95], v19
L_K_have:
    s_cmp_eq_u32 s58, 0
    s_waitcnt lgkmcnt(0)
    v_lshlrev_b32 v56, 16, v80
    v_and_b32 v57, s50, v80
    v_lshlrev_b32 v58, 16, v81
    v_and_b32 v59, s50, v81
    v_lshlrev_b32 v60, 16, v82
    v_and_b32 v61, s50, v82
    v_lshlrev_b32 v62, 16, v83
    v_and_b32 v63, s50, v83
    v_pk_mul_f32 v[56:57], v[56:57], s[36:37]
    v_pk_mul_f32 v[58:59], v[58:59], s[36:37]
    v_pk_mul_f32 v[60:61], v[60:61], s[36:37]
    v_pk_mul_f32 v[62:63], v[62:63], s[36:37]
    v_cvt_pk_bf16_f32 v80, v56, v57
    v_cvt_pk_bf16_f32 v81, v58, v59
    v_cvt_pk_bf16_f32 v82, v60, v61
    v_cvt_pk_bf16_f32 v83, v62, v63
    s_cbranch_scc0 L_K_other
    buffer_load_dwordx4 v12, s[20:23], s56 offen offset:0 nt lds
    buffer_load_dwordx4 v13, s[20:23], s56 offen offset:1024 nt lds
    buffer_load_dwordx4 v14, s[20:23], s56 offen offset:2048 nt lds
    buffer_load_dwordx4 v15, s[20:23], s56 offen offset:3072 nt lds
L_K_issued:
    s_mov_b64 exec, 1
    ds_add_rtn_u32 v7, v5, v6
    s_mov_b64 exec, -1
L_K_feat:
    v_lshlrev_b32 v56, 16, v84
    v_and_b32 v57, s50, v84
    v_lshlrev_b32 v58, 16, v85
    v_and_b32 v59, s50, v85
    v_lshlrev_b32 v60, 16, v86
    v_and_b32 v61, s50, v86
    v_lshlrev_b32 v62, 16, v87
    v_and_b32 v63, s50, v87
    v_pk_mul_f32 v[56:57], v[56:57], s[36:37]
    v_pk_mul_f32 v[58:59], v[58:59], s[36:37]
    v_pk_mul_f32 v[60:61], v[60:61], s[36:37]
    v_pk_mul_f32 v[62:63], v[62:63], s[36:37]
    v_cvt_pk_bf16_f32 v84, v56, v57
    v_cvt_pk_bf16_f32 v85, v58, v59
    v_cvt_pk_bf16_f32 v86, v60, v61
    v_cvt_pk_bf16_f32 v87, v62, v63
    v_lshlrev_b32 v56, 16, v88
    v_and_b32 v57, s50, v88
    v_lshlrev_b32 v58, 16, v89
    v_and_b32 v59, s50, v89
    v_lshlrev_b32 v60, 16, v90
    v_and_b32 v61, s50, v90
    v_lshlrev_b32 v62, 16, v91
    v_and_b32 v63, s50, v91
    v_pk_mul_f32 v[56:57], v[56:57], s[36:37]
    v_pk_mul_f32 v[58:59], v[58:59], s[36:37]
    v_pk_mul_f32 v[60:61], v[60:61], s[36:37]
    v_pk_mul_f32 v[62:63], v[62:63], s[36:37]
    v_cvt_pk_bf16_f32 v88, v56, v57
    v_cvt_pk_bf16_f32 v89, v58, v59
    v_cvt_pk_bf16_f32 v90, v60, v61
    v_cvt_pk_bf16_f32 v91, v62, v63
    v_lshlrev_b32 v56, 16, v92
    v_and_b32 v57, s50, v92
    v_lshlrev_b32 v58, 16, v93
    v_and_b32 v59, s50, v93
    v_lshlrev_b32 v60, 16, v94
    v_and_b32 v61, s50, v94
    v_lshlrev_b32 v62, 16, v95
    v_and_b32 v63, s50, v95
    v_pk_mul_f32 v[56:57], v[56:57], s[36:37]
    v_pk_mul_f32 v[58:59], v[58:59], s[36:37]
    v_pk_mul_f32 v[60:61], v[60:61], s[36:37]
    v_pk_mul_f32 v[62:63], v[62:63], s[36:37]
    v_cvt_pk_bf16_f32 v92, v56, v57
    v_cvt_pk_bf16_f32 v93, v58, v59
    v_cvt_pk_bf16_f32 v94, v60, v61
    v_cvt_pk_bf16_f32 v95, v62, v63
    s_nop 0
    v_mfma_f32_16x16x32_bf16 v[48:51], v[24:27], v[80:83], 0
    v_mfma_f32_16x16x32_bf16 v[52:55], v[80:83], v[80:83], 0
    v_mfma_f32_16x16x32_bf16 v[48:51], v[28:31], v[84:87], v[48:51]
    v_mfma_f32_16x16x32_bf16 v[52:55], v[84:87], v[84:87], v[52:55]
    v_mfma_f32_16x16x32_bf16 v[48:51], v[32:35], v[88:91], v[48:51]
    v_mfma_f32_16x16x32_bf16 v[52:55], v[88:91], v[88:91], v[52:55]
    v_mfma_f32_16x16x32_bf16 v[48:51], v[36:39], v[92:95], v[48:51]
    v_mfma_f32_16x16x32_bf16 v[52:55], v[92:95], v[92:95], v[52:55]
    s_nop 6
    v_cvt_pk_bf16_f32 v44, v48, v49
    v_cvt_pk_bf16_f32 v45, v50, v51
    v_cvt_pk_bf16_f32 v46, v52, v53
    v_cvt_pk_bf16_f32 v47, v54, v55
    v_and_b32 v46, v3, v46
    v_and_b32 v47, v4, v47
    s_nop 1
    v_mfma_f32_16x16x32_bf16 v[48:51], v[40:43], v[44:47], 0
    s_nop 7
    v_cvt_pk_bf16_f32 v56, v48, v49
    v_cvt_pk_bf16_f32 v57, v50, v51
    v_lshlrev_b32 v60, 16, v56
    v_and_b32 v61, s50, v56
    v_lshlrev_b32 v62, 16, v57
    v_and_b32 v63, s50, v57
    v_mul_f32 v60, s51, v60
    v_mul_f32 v61, s51, v61
    v_mul_f32 v62, s51, v62
    v_mul_f32 v63, s51, v63
    v_exp_f32 v60, v60
    v_exp_f32 v61, v61
    v_exp_f32 v62, v62
    v_exp_f32 v63, v63
    s_nop 0
    v_cvt_pk_bf16_f32 v56, v60, v61
    v_cvt_pk_bf16_f32 v57, v62, v63
    v_lshlrev_b32 v60, 16, v56
    v_and_b32 v61, s50, v56
    v_lshlrev_b32 v62, 16, v57
    v_and_b32 v63, s50, v57
    v_fma_f32 v60, v60, s52, v8
    v_fma_f32 v61, v61, s52, v8
    v_fma_f32 v62, v62, s52, v8
    v_fma_f32 v63, v63, s52, v8
    v_cvt_pk_bf16_f32 v72, v60, v61
    v_cvt_pk_bf16_f32 v73, v62, v63
    s_cmp_eq_u32 s68, 0
    s_cbranch_scc1 L_first
L_K_w:
    v_add_u32 v58, s59, v10
    v_mfma_f32_16x16x16_bf16 v[48:51], v[74:75], v[72:73], 0
    s_nop 7
    v_and_b32 v56, s50, v48
    v_sub_f32 v57, v48, v56
    v_add_f32 v11, v11, v48
    v_cvt_pk_bf16_f32 v56, v57, v56
    s_mov_b64 exec, 0xffff
    ds_write_b32 v58, v56 offset:29248
    s_mov_b64 exec, -1
    s_cmp_eq_u32 s58, 0
    s_cbranch_scc1 L_decode
    v_add_f32_dpp v70, v11, v11 row_ror:8 row_mask:0xf bank_mask:0xf
    s_nop 1
    v_add_f32_dpp v70, v70, v70 row_ror:4 row_mask:0xf bank_mask:0xf
    s_nop 1
    v_add_f32_dpp v70, v70, v70 row_ror:2 row_mask:0xf bank_mask:0xf
    s_nop 1
    v_add_f32_dpp v70, v70, v70 row_ror:1 row_mask:0xf bank_mask:0xf
    s_cmp_eq_u32 s58, 1
    s_cbranch_scc1 L_decode
    s_branch L_exit
L_topV:
    v_add_u32 v60, s59, v9
L_V_w:
    ds_read_b128 v[76:79], v60 offset:29248
    s_waitcnt lgkmcnt(0)
    v_cmp_eq_u32 vcc, 0, v76
    s_cbranch_vccnz L_V_w
    v_perm_b32 v112, v76, v76, v20
    v_perm_b32 v113, v76, v76, v21
    v_perm_b32 v114, v76, v76, v22
    v_perm_b32 v115, v76, v76, v23
    v_perm_b32 v116, v77, v77, v20
    v_perm_b32 v117, v77, v77, v21
    v_perm_b32 v118, v77, v77, v22
    v_perm_b32 v119, v77, v77, v23
    v_perm_b32 v120, v78, v78, v20
    v_perm_b32 v121, v78, v78, v21
    v_perm_b32 v122, v78, v78, v22
    v_perm_b32 v123, v78, v78, v23
    v_perm_b32 v124, v79, v79, v20
    v_perm_b32 v125, v79, v79, v21
    v_perm_b32 v126, v79, v79, v22
    v_perm_b32 v127, v79, v79, v23
    s_waitcnt vmcnt(0)
    v_mfma_f32_16x16x32_bf16 v[64:67], v[112:115], v[96:99], v[64:67]
    v_mfma_f32_16x16x32_bf16 v[64:67], v[116:119], v[100:103], v[64:67]
    v_mfma_f32_16x16x32_bf16 v[64:67], v[120:123], v[104:107], v[64:67]
    s_cmp_eq_u32 s58, 1
    v_mfma_f32_16x16x32_bf16 v[64:67], v[124:127], v[108:111], v[64:67]
    s_cbranch_scc0 L_exit
    buffer_load_dwordx4 v[96:99], v2, s[24:27], s56 offen offset:0 nt
    buffer_load_dwordx4 v[100:103], v2, s[24:27], s56 offen offset:1024 nt
    buffer_load_dwordx4 v[104:107], v2, s[24:27], s56 offen offset:2048 nt
    buffer_load_dwordx4 v[108:111], v2, s[24:27], s56 offen offset:3072 nt
    s_mov_b64 exec, 1
    ds_add_rtn_u32 v7, v5, v6
    s_mov_b64 exec, -1
L_decode:
    s_waitcnt lgkmcnt(0)
    v_readfirstlane_b32 s55, v7
    s_mov_b32 s57, s58
    s_mov_b32 s59, s60
    s_add_u32 s55, s55, 12
    s_cmp_ge_u32 s55, s61
    s_cbranch_scc1 L_end
L_own:
    s_bfe_u32 s58, s55, 0x10008
    s_and_b32 s60, s55, 255
L_off:
    s_lshl_b32 s60, s60, 6
    s_bitcmp1_b32 s55, 0
    s_cselect_b32 s48, 0x20a000, 0
    s_xor_b32 s56, s67, s48
    s_bitcmp1_b32 s55, 1
    s_cselect_b32 s48, 0x18000, 0
    s_xor_b32 s56, s56, s48
    s_bitcmp1_b32 s55, 2
    s_cselect_b32 s48, 0x208000, 0
    s_xor_b32 s56, s56, s48
    s_bitcmp1_b32 s55, 3
    s_cselect_b32 s48, 0x780000, 0
    s_xor_b32 s56, s56, s48
    s_bitcmp1_b32 s55, 4
    s_cselect_b32 s48, 0x2e6000, 0
    s_xor_b32 s56, s56, s48
    s_bitcmp1_b32 s55, 5
    s_cselect_b32 s48, 0x4ac000, 0
    s_xor_b32 s56, s56, s48
    s_bitcmp1_b32 s55, 6
    s_cselect_b32 s48, 0x484000, 0
    s_xor_b32 s56, s56, s48
    s_bitcmp1_b32 s55, 7
    s_cselect_b32 s48, 0x28e000, 0
    s_xor_b32 s56, s56, s48
L_dispatch:
    s_cmp_eq_u32 s57, 1
    s_cbranch_scc1 L_topV
    s_branch L_topK
L_K_other:
    s_cmp_eq_u32 s58, 1
    s_cbranch_scc0 L_K_feat
    buffer_load_dwordx4 v[96:99], v2, s[24:27], s56 offen offset:0 nt
    buffer_load_dwordx4 v[100:103], v2, s[24:27], s56 offen offset:1024 nt
    buffer_load_dwordx4 v[104:107], v2, s[24:27], s56 offen offset:2048 nt
    buffer_load_dwordx4 v[108:111], v2, s[24:27], s56 offen offset:3072 nt
    s_branch L_K_issued
L_first:
    v_lshlrev_b32 v56, 3, v1
    s_cmp_eq_u32 s58, 3
    s_cbranch_scc1 L_control
    s_mov_b32 s68, 1
L_getpq:
    ds_read_b64 v[74:75], v56 offset:28960
    s_waitcnt lgkmcnt(0)
    v_cmp_eq_u32 vcc, 0, v74
    s_cbranch_vccnz L_getpq
    s_branch L_K_w
L_end:
    s_cmp_lg_u32 s62, 0
    s_cbranch_scc1 L_end2
    ds_read_b96 v[56:58], v5 offset:16
    s_waitcnt lgkmcnt(0)
    v_readfirstlane_b32 s62, v58
    v_readfirstlane_b32 s63, v56
    v_readfirstlane_b32 s64, v57
    s_branch L_end
L_end2:
    s_cmp_ge_u32 s55, 65536
    s_cbranch_scc0 L_take
    s_add_u32 s61, s63, 65536
    s_cmp_lt_u32 s55, s61
    s_cbranch_scc1 L_own
L_last:
    s_mov_b32 s58, 2
    s_branch L_dispatch
L_take:
    s_sub_u32 s40, s55, 512
    s_cmp_lt_u32 s40, s64
    s_cbranch_scc0 L_last
    s_lshl_b32 s41, s40, 2
    v_mov_b32 v56, s41
    ds_read_b32 v56, v56 offset:28992
    s_add_u32 s60, s40, 256
    s_mov_b32 s58, 1
    s_waitcnt lgkmcnt(0)
    v_readfirstlane_b32 s55, v56
    s_bitcmp1_b32 s55, 8
    s_cselect_b32 s48, 0x12000, 0
    s_xor_b32 s67, s66, s48
    s_bitcmp1_b32 s55, 9
    s_cselect_b32 s48, 0x331000, 0
    s_xor_b32 s67, s67, s48
    s_bitcmp1_b32 s55, 10
    s_cselect_b32 s48, 0x1b3000, 0
    s_xor_b32 s67, s67, s48
    s_branch L_off
L_exit:
    v_add_u32 v56, s69, v2
    s_nop 6
    v_permlane32_swap_b32 v64, v66
    v_permlane32_swap_b32 v65, v67
    v_pk_add_f32 v[68:69], v[64:65], v[66:67]
    ds_write_b96 v56, v[68:70]
    s_mov_b64 exec, 1
    ds_add_u32 v5, v6 offset:4
    s_waitcnt lgkmcnt(0)
    s_endpgm
L_control:
    ds_write_b64 v56, v[72:73] offset:28960
    s_and_b32 s54, s2, 7
    s_lshl_b32 s40, s53, 13
    s_add_u32 s28, s16, s40
    s_addc_u32 s29, s17, 0
    s_mov_b32 s30, 8192
    s_mov_b32 s31, 0x20000
    s_lshl_b32 s40, s53, 11
    s_add_u32 s40, s40, 0x40000
    s_add_u32 s38, s16, s40
    s_addc_u32 s39, s17, 0
    s_mul_i32 s40, s53, 0x1400
    s_add_u32 s40, s40, 0x60000
    s_add_u32 s32, s16, s40
    s_addc_u32 s33, s17, 0
    s_mov_b32 s34, 4096
    s_mov_b32 s35, 0x20000
    s_lshl_b32 s40, s53, 3
    s_add_u32 s14, s14, s40
    s_addc_u32 s15, s15, 0
    s_add_u32 s70, s54, 0
    s_and_b32 s70, s70, 7
    s_lshl_b32 s70, s70, 10
    s_add_u32 s71, s54, 1
    s_and_b32 s71, s71, 7
    s_lshl_b32 s71, s71, 10
    s_add_u32 s72, s54, 2
    s_and_b32 s72, s72, 7
    s_lshl_b32 s72, s72, 10
    s_add_u32 s73, s54, 3
    s_and_b32 s73, s73, 7
    s_lshl_b32 s73, s73, 10
    s_add_u32 s74, s54, 4
    s_and_b32 s74, s74, 7
    s_lshl_b32 s74, s74, 10
    s_add_u32 s75, s54, 5
    s_and_b32 s75, s75, 7
    s_lshl_b32 s75, s75, 10
    s_add_u32 s76, s54, 6
    s_and_b32 s76, s76, 7
    s_lshl_b32 s76, s76, 10
    s_add_u32 s77, s54, 7
    s_and_b32 s77, s77, 7
    s_lshl_b32 s77, s77, 10
    s_mov_b32 s56, 0x0c0c0400
    s_mov_b32 s59, 0x04000c0c
    s_mov_b32 s60, 0xffffff00
    v_mov_b32 v112, 0
    v_and_b32 v113, 7, v0
    v_lshlrev_b32 v113, 8, v113
    v_and_b32 v114, 15, v0
    v_bfe_u32 v58, v0, 4, 1
    v_lshl_add_u32 v114, v114, 1, v58
    v_lshrrev_b32 v58, 5, v0
    v_lshl_add_u32 v114, v114, 1, v58
    s_lshl_b32 s40, s53, 8
    v_lshl_add_u32 v114, v114, 2, s40
    s_cmp_lg_u32 s54, 0
    s_cbranch_scc1 L_notag
    s_memrealtime s[40:41]
    buffer_load_dword v96, v2, s[28:31], s70 offen offset:12 sc1
    buffer_load_dword v97, v2, s[28:31], s71 offen offset:12 sc1
    buffer_load_dword v98, v2, s[28:31], s72 offen offset:12 sc1
    buffer_load_dword v99, v2, s[28:31], s73 offen offset:12 sc1
    buffer_load_dword v100, v2, s[28:31], s74 offen offset:12 sc1
    buffer_load_dword v101, v2, s[28:31], s75 offen offset:12 sc1
    buffer_load_dword v102, v2, s[28:31], s76 offen offset:12 sc1
    buffer_load_dword v103, v2, s[28:31], s77 offen offset:12 sc1
    global_load_dword v104, v113, s[38:39] offset:4 sc1
    buffer_load_dwordx4 v[80:83], v2, s[32:35], 0 offen offset:0 sc1
    buffer_load_dwordx4 v[84:87], v2, s[32:35], 0 offen offset:1024 sc1
    buffer_load_dwordx4 v[88:91], v2, s[32:35], 0 offen offset:2048 sc1
    buffer_load_dwordx4 v[92:95], v2, s[32:35], 0 offen offset:3072 sc1
    s_waitcnt vmcnt(0) lgkmcnt(0)
    v_perm_b32 v105, v81, v80, s56
    v_perm_b32 v63, v83, v82, s59
    v_or_b32 v105, v105, v63
    v_perm_b32 v106, v85, v84, s56
    v_perm_b32 v63, v87, v86, s59
    v_or_b32 v106, v106, v63
    v_perm_b32 v107, v89, v88, s56
    v_perm_b32 v63, v91, v90, s59
    v_or_b32 v107, v107, v63
    v_perm_b32 v108, v93, v92, s56
    v_perm_b32 v63, v95, v94, s59
    v_or_b32 v108, v108, v63
    s_or_b32 s40, s40, 1
L_pick:
    s_add_u32 s40, s40, 2
    v_cmp_eq_u32 vcc, s40, v96
    v_cmp_eq_u32 s[42:43], s40, v97
    s_or_b64 vcc, vcc, s[42:43]
    v_cmp_eq_u32 s[42:43], s40, v98
    s_or_b64 vcc, vcc, s[42:43]
    v_cmp_eq_u32 s[42:43], s40, v99
    s_or_b64 vcc, vcc, s[42:43]
    v_cmp_eq_u32 s[42:43], s40, v100
    s_or_b64 vcc, vcc, s[42:43]
    v_cmp_eq_u32 s[42:43], s40, v101
    s_or_b64 vcc, vcc, s[42:43]
    v_cmp_eq_u32 s[42:43], s40, v102
    s_or_b64 vcc, vcc, s[42:43]
    v_cmp_eq_u32 s[42:43], s40, v103
    s_or_b64 vcc, vcc, s[42:43]
    v_cmp_eq_u32 s[42:43], s40, v104
    s_or_b64 vcc, vcc, s[42:43]
    v_cmp_eq_u32 s[42:43], s40, v105
    s_or_b64 vcc, vcc, s[42:43]
    v_cmp_eq_u32 s[42:43], s40, v106
    s_or_b64 vcc, vcc, s[42:43]
    v_cmp_eq_u32 s[42:43], s40, v107
    s_or_b64 vcc, vcc, s[42:43]
    v_cmp_eq_u32 s[42:43], s40, v108
    s_or_b64 vcc, vcc, s[42:43]
    s_cbranch_vccnz L_pick
    v_mov_b32 v96, s40
    s_mov_b64 exec, 1
    global_store_dword v112, v96, s[14:15] sc1
    s_mov_b64 exec, -1
L_notag:
L_w1:
    s_sleep 16
    ds_read_b32 v56, v5 offset:0
    s_waitcnt lgkmcnt(0)
    v_cmp_gt_u32 vcc, 408, v56
    s_cbranch_vccnz L_w1
L_gettag:
    global_load_dword v71, v112, s[14:15] sc1
    s_waitcnt vmcnt(0)
    v_cmp_eq_u32 vcc, 0, v71
    s_cbranch_vccnz L_gettag
    v_readfirstlane_b32 s65, v71
L_watch:
    global_load_dword v57, v113, s[38:39] offset:4 sc1
    s_waitcnt vmcnt(0)
    ds_read_b32 v56, v5
    s_memrealtime s[40:41]
    v_cmp_eq_u32 s[42:43], s65, v57
    s_waitcnt lgkmcnt(0)
    v_cmp_le_u32 vcc, 468, v56
    s_or_b64 vcc, vcc, s[42:43]
    s_cbranch_vccz L_watch
    s_sub_u32 s40, s40, s65
    s_min_u32 s40, s40, 0x3fffff
    v_lshl_or_b32 v70, v56, 22, s40
    s_lshl_b32 s42, s54, 8
    v_mov_b32 v57, s42
    s_mov_b64 exec, 1
    global_store_dwordx2 v57, v[70:71], s[38:39] sc1
    s_mov_b64 exec, -1
L_gather:
    global_load_dwordx2 v[58:59], v113, s[38:39] sc1
    s_waitcnt vmcnt(0)
    v_cmp_ne_u32 vcc, s65, v59
    s_cbranch_vccnz L_gather
    v_lshrrev_b32 v59, 22, v58
    v_and_b32 v58, 0x3fffff, v58
    v_cvt_f32_u32 v59, v59
    v_cvt_f32_u32 v58, v58
    v_add_f32 v59, 0xc0000000, v59
    s_nop 1
    v_add_f32_dpp v60, v58, v58 quad_perm:[1,0,3,2] row_mask:0xf bank_mask:0xf
    v_add_f32_dpp v61, v59, v59 quad_perm:[1,0,3,2] row_mask:0xf bank_mask:0xf
    s_nop 0
    v_add_f32_dpp v60, v60, v60 quad_perm:[2,3,0,1] row_mask:0xf bank_mask:0xf
    v_add_f32_dpp v61, v61, v61 quad_perm:[2,3,0,1] row_mask:0xf bank_mask:0xf
    s_nop 0
    v_add_f32_dpp v60, v60, v60 row_half_mirror row_mask:0xf bank_mask:0xf
    v_add_f32_dpp v61, v61, v61 row_half_mirror row_mask:0xf bank_mask:0xf
    s_nop 0
    v_rcp_f32 v60, v60
    v_mul_f32 v58, v58, v61
    v_fma_f32 v58, v58, v60, -v59
    v_mov_b32 v60, 0x3f87ae14
    v_mul_f32 v59, 0xc3800000, v58
    v_fma_f32 v58, v58, v60, 0.5
    v_cvt_u32_f32 v59, v59
    v_cvt_u32_f32 v58, v58
    v_min_u32 v59, 0x100000, v59
    v_min_u32 v58, 64, v58
    s_nop 0
    v_add_u32_dpp v61, v59, v59 row_shr:1 row_mask:0xf bank_mask:0xf bound_ctrl:1
    v_add_u32_dpp v60, v58, v58 row_shr:1 row_mask:0xf bank_mask:0xf bound_ctrl:1
    s_nop 0
    v_add_u32_dpp v61, v61, v61 row_shr:2 row_mask:0xf bank_mask:0xf bound_ctrl:1
    v_add_u32_dpp v60, v60, v60 row_shr:2 row_mask:0xf bank_mask:0xf bound_ctrl:1
    s_nop 0
    v_add_u32_dpp v61, v61, v61 row_shr:4 row_mask:0xf bank_mask:0xf bound_ctrl:1
    v_add_u32_dpp v60, v60, v60 row_shr:4 row_mask:0xf bank_mask:0xf bound_ctrl:1
    s_nop 0
    v_readlane_b32 s40, v61, 7
    v_sub_u32 v59, v61, v59
    v_sub_u32 v58, v60, v58
    s_cmp_eq_u32 s40, 0
    s_cselect_b32 s41, 0, 64
    v_min_u32 v60, s41, v60
    v_min_u32 v58, s41, v58
    v_cvt_f32_u32 v62, s40
    v_readlane_b32 s41, v60, 7
    v_rcp_f32 v62, v62
    v_cvt_f32_u32 v59, v59
    v_cvt_f32_u32 v57, s41
    v_cvt_f32_u32 v61, v61
    v_mul_f32 v62, v62, v57
    v_fma_f32 v59, v59, v62, 0.5
    v_fma_f32 v61, v61, v62, 0.5
    v_cvt_u32_f32 v59, v59
    v_cvt_u32_f32 v61, v61
    v_readlane_b32 s42, v58, s54
    v_readlane_b32 s43, v60, s54
    v_readlane_b32 s44, v59, s54
    v_readlane_b32 s45, v61, s54
    s_sub_u32 s64, s45, s44
    s_sub_u32 s43, s43, s42
    s_sub_u32 s63, 512, s43
    v_mov_b32 v76, s63
    v_mov_b32 v77, s64
    v_mov_b32 v78, 1
    s_cmp_eq_u32 s43, 0
    s_cbranch_scc1 L_taker
    v_mov_b32 v57, 65536
    s_mov_b64 exec, 1
    ds_write_b96 v5, v[76:78] offset:16
    ds_add_rtn_u32 v56, v5, v57
    s_mov_b64 exec, -1
    v_lshrrev_b32 v84, 0, v71
    v_lshrrev_b32 v85, 8, v71
    v_lshrrev_b32 v86, 16, v71
    v_lshrrev_b32 v87, 24, v71
    v_lshrrev_b32 v88, 2, v0
    v_add_u32 v88, s63, v88
    s_lshl_b32 s40, s63, 6
    v_add_u32 v89, s40, v2
    v_bfrev_b32 v90, 1
    s_lshl_b32 s42, s42, 6
    s_waitcnt lgkmcnt(0)
    v_readfirstlane_b32 s40, v56
    s_add_u32 s40, s40, 12
L_give:
    v_cmp_gt_u32 vcc, 512, v88
    s_and_b64 exec, exec, vcc
    s_cbranch_execz L_moved
L_give1:
    ds_read_b128 v[76:79], v89 offset:12864
    s_waitcnt lgkmcnt(0)
    v_cmp_eq_u32 vcc, 0, v76
    s_cbranch_vccnz L_give1
    v_cmp_gt_u32 vcc, s40, v88
    v_lshlrev_b32 v56, 16, v76
    v_and_b32 v57, s50, v76
    v_add_f32 v56, v56, v57
    v_cndmask_b32 v56, v56, v90, vcc
    v_bfi_b32 v80, s60, v56, v84
    v_lshlrev_b32 v56, 16, v77
    v_and_b32 v57, s50, v77
    v_add_f32 v56, v56, v57
    v_cndmask_b32 v56, v56, v90, vcc
    v_bfi_b32 v81, s60, v56, v85
    v_lshlrev_b32 v56, 16, v78
    v_and_b32 v57, s50, v78
    v_add_f32 v56, v56, v57
    v_cndmask_b32 v56, v56, v90, vcc
    v_bfi_b32 v82, s60, v56, v86
    v_lshlrev_b32 v56, 16, v79
    v_and_b32 v57, s50, v79
    v_add_f32 v56, v56, v57
    v_cndmask_b32 v56, v56, v90, vcc
    v_bfi_b32 v83, s60, v56, v87
    buffer_store_dwordx4 v[80:83], v2, s[32:35], s42 offen sc1
    s_add_u32 s42, s42, 1024
    v_add_u32 v88, 16, v88
    v_add_u32 v89, 1024, v89
    s_branch L_give
L_taker:
    v_add_u32 v88, s44, v0
    v_mov_b32 v89, 0
    v_readlane_b32 s40, v60, 7
    s_sub_u32 s41, 2048, s40
    v_mov_b32 v90, s41
    v_cmp_gt_u32 vcc, s40, v88
    s_nop 1
    v_cndmask_b32 v89, v89, v90, vcc
    v_readlane_b32 s40, v60, 6
    s_sub_u32 s41, 1792, s40
    v_mov_b32 v90, s41
    v_cmp_gt_u32 vcc, s40, v88
    s_nop 1
    v_cndmask_b32 v89, v89, v90, vcc
    v_readlane_b32 s40, v60, 5
    s_sub_u32 s41, 1536, s40
    v_mov_b32 v90, s41
    v_cmp_gt_u32 vcc, s40, v88
    s_nop 1
    v_cndmask_b32 v89, v89, v90, vcc
    v_readlane_b32 s40, v60, 4
    s_sub_u32 s41, 1280, s40
    v_mov_b32 v90, s41
    v_cmp_gt_u32 vcc, s40, v88
    s_nop 1
    v_cndmask_b32 v89, v89, v90, vcc
    v_readlane_b32 s40, v60, 3
    s_sub_u32 s41, 1024, s40
    v_mov_b32 v90, s41
    v_cmp_gt_u32 vcc, s40, v88
    s_nop 1
    v_cndmask_b32 v89, v89, v90, vcc
    v_readlane_b32 s40, v60, 2
    s_sub_u32 s41, 768, s40
    v_mov_b32 v90, s41
    v_cmp_gt_u32 vcc, s40, v88
    s_nop 1
    v_cndmask_b32 v89, v89, v90, vcc
    v_readlane_b32 s40, v60, 1
    s_sub_u32 s41, 512, s40
    v_mov_b32 v90, s41
    v_cmp_gt_u32 vcc, s40, v88
    s_nop 1
    v_cndmask_b32 v89, v89, v90, vcc
    v_readlane_b32 s40, v60, 0
    s_sub_u32 s41, 256, s40
    v_mov_b32 v90, s41
    v_cmp_gt_u32 vcc, s40, v88
    s_nop 1
    v_cndmask_b32 v89, v89, v90, vcc
    v_add_u32 v89, v89, v88
    v_lshlrev_b32 v90, 2, v0
    ds_write_b32 v90, v89 offset:28992
    s_mov_b64 exec, 1
    ds_write_b96 v5, v[76:78] offset:16
    s_mov_b64 exec, -1
    v_lshrrev_b32 v88, 2, v0
    v_mov_b32 v89, v2
    s_lshl_b32 s44, s44, 6
L_get:
    v_cmp_gt_u32 vcc, s64, v88
    s_and_b64 exec, exec, vcc
    s_cbranch_execz L_moved
L_get1:
    buffer_load_dwordx4 v[80:83], v2, s[32:35], s44 offen sc1
    s_waitcnt vmcnt(0)
    v_perm_b32 v56, v81, v80, s56
    v_perm_b32 v63, v83, v82, s59
    v_or_b32 v56, v56, v63
    v_cmp_ne_u32 vcc, s65, v56
    s_cbranch_vccnz L_get1
    v_and_b32 v56, s60, v80
    v_and_b32 v57, s50, v80
    v_sub_f32 v56, v56, v57
    v_cvt_pk_bf16_f32 v84, v56, v57
    v_and_b32 v56, s60, v81
    v_and_b32 v57, s50, v81
    v_sub_f32 v56, v56, v57
    v_cvt_pk_bf16_f32 v85, v56, v57
    v_and_b32 v56, s60, v82
    v_and_b32 v57, s50, v82
    v_sub_f32 v56, v56, v57
    v_cvt_pk_bf16_f32 v86, v56, v57
    v_and_b32 v56, s60, v83
    v_and_b32 v57, s50, v83
    v_sub_f32 v56, v56, v57
    v_cvt_pk_bf16_f32 v87, v56, v57
    ds_write_b128 v89, v[84:87] offset:45632
    s_add_u32 s44, s44, 1024
    v_add_u32 v88, 16, v88
    v_add_u32 v89, 1024, v89
    s_branch L_get
L_moved:
    s_mov_b64 exec, -1
L_w3:
    s_sleep 2
    ds_read_b32 v56, v5 offset:4
    s_waitcnt lgkmcnt(0)
    v_cmp_gt_u32 vcc, 1, v56
    s_cbranch_vccnz L_w3
L_w4:
    ds_read_b32 v56, v5 offset:4
    s_waitcnt lgkmcnt(0)
    v_cmp_gt_u32 vcc, 6, v56
    s_cbranch_vccnz L_w4
    ds_read_b96 v[24:26], v2 offset:0
    ds_read_b96 v[28:30], v2 offset:4096
    ds_read_b96 v[32:34], v2 offset:8192
    ds_read_b96 v[36:38], v2 offset:12288
    ds_read_b96 v[116:118], v2 offset:16384
    ds_read_b96 v[120:122], v2 offset:20480
    buffer_load_dwordx4 v[80:83], v2, s[28:31], s71 offen sc1
    buffer_load_dwordx4 v[84:87], v2, s[28:31], s72 offen sc1
    buffer_load_dwordx4 v[88:91], v2, s[28:31], s73 offen sc1
    buffer_load_dwordx4 v[92:95], v2, s[28:31], s74 offen sc1
    buffer_load_dwordx4 v[96:99], v2, s[28:31], s75 offen sc1
    buffer_load_dwordx4 v[100:103], v2, s[28:31], s76 offen sc1
    buffer_load_dwordx4 v[104:107], v2, s[28:31], s77 offen sc1
    s_waitcnt lgkmcnt(4)
    v_pk_add_f32 v[68:69], v[24:25], v[28:29]
    v_add_f32 v70, v26, v30
    s_waitcnt lgkmcnt(3)
    v_pk_add_f32 v[68:69], v[68:69], v[32:33]
    v_add_f32 v70, v70, v34
    s_waitcnt lgkmcnt(2)
    v_pk_add_f32 v[68:69], v[68:69], v[36:37]
    v_add_f32 v70, v70, v38
    s_waitcnt lgkmcnt(1)
    v_pk_add_f32 v[68:69], v[68:69], v[116:117]
    v_add_f32 v70, v70, v118
    s_waitcnt lgkmcnt(0)
    v_pk_add_f32 v[68:69], v[68:69], v[120:121]
    v_add_f32 v70, v70, v122
    buffer_store_dwordx4 v[68:71], v2, s[28:31], s70 offen sc1
    s_waitcnt vmcnt(1)
L_check:
    v_cmp_ne_u32 vcc, s65, v83
    v_cmp_ne_u32 s[40:41], s65, v87
    s_or_b64 vcc, vcc, s[40:41]
    v_cmp_ne_u32 s[40:41], s65, v91
    s_or_b64 vcc, vcc, s[40:41]
    v_cmp_ne_u32 s[40:41], s65, v95
    s_or_b64 vcc, vcc, s[40:41]
    v_cmp_ne_u32 s[40:41], s65, v99
    s_or_b64 vcc, vcc, s[40:41]
    v_cmp_ne_u32 s[40:41], s65, v103
    s_or_b64 vcc, vcc, s[40:41]
    v_cmp_ne_u32 s[40:41], s65, v107
    s_or_b64 vcc, vcc, s[40:41]
    s_cbranch_vccz L_final
    s_cmp_lg_u32 s62, 0
    s_cbranch_scc1 L_done
    s_mov_b32 s62, 1
    s_waitcnt vmcnt(0)
    buffer_load_dwordx4 v[80:83], v2, s[28:31], s71 offen sc1
    buffer_load_dwordx4 v[84:87], v2, s[28:31], s72 offen sc1
    buffer_load_dwordx4 v[88:91], v2, s[28:31], s73 offen sc1
    buffer_load_dwordx4 v[92:95], v2, s[28:31], s74 offen sc1
    buffer_load_dwordx4 v[96:99], v2, s[28:31], s75 offen sc1
    buffer_load_dwordx4 v[100:103], v2, s[28:31], s76 offen sc1
    buffer_load_dwordx4 v[104:107], v2, s[28:31], s77 offen sc1
    s_waitcnt vmcnt(0)
    s_branch L_check
L_final:
    v_add_f32 v106, v106, v70
    v_pk_add_f32 v[104:105], v[104:105], v[68:69]
    v_add_f32 v82, v82, v86
    v_pk_add_f32 v[80:81], v[80:81], v[84:85]
    v_add_f32 v90, v90, v94
    v_pk_add_f32 v[88:89], v[88:89], v[92:93]
    v_add_f32 v98, v98, v102
    v_pk_add_f32 v[96:97], v[96:97], v[100:101]
    v_add_f32 v82, v82, v90
    v_pk_add_f32 v[80:81], v[80:81], v[88:89]
    v_add_f32 v98, v98, v106
    v_pk_add_f32 v[96:97], v[96:97], v[104:105]
    v_add_f32 v82, v82, v98
    v_pk_add_f32 v[80:81], v[80:81], v[96:97]
    v_cvt_pk_bf16_f32 v58, v82, v82
    v_cvt_pk_bf16_f32 v59, v80, v81
    v_and_b32 v58, s50, v58
    v_add_f32 v58, v8, v58
    v_cvt_pk_bf16_f32 v58, v58, v58
    v_and_b32 v58, s50, v58
    v_rcp_f32 v58, v58
    v_lshlrev_b32 v60, 16, v59
    v_and_b32 v61, s50, v59
    v_mul_f32 v60, v58, v60
    v_mul_f32 v61, v58, v61
    v_cvt_pk_bf16_f32 v59, v60, v61
    global_store_dword v114, v59, s[12:13]
L_done:
    s_endpgm
.section .rodata,"a"
.p2align 6
.amdhsa_kernel standalone__linear_kernel_rfa__decode_kernel
  .amdhsa_next_free_vgpr 128
  .amdhsa_next_free_sgpr 78
  .amdhsa_accum_offset 128
  .amdhsa_group_segment_fixed_size 0
  .amdhsa_kernarg_size 56
  .amdhsa_user_sgpr_count 2
  .amdhsa_user_sgpr_kernarg_segment_ptr 1
  .amdhsa_system_sgpr_workgroup_id_x 1
  .amdhsa_float_denorm_mode_32 3
.end_amdhsa_kernel
```
